```python
import torch

def _softmax(x, axis=-1):
    return torch.softmax(x, dim=axis)
def _gelu(x):
    return torch.nn.functional.gelu(x, approximate="tanh")
def _silu(x):
    return torch.nn.functional.silu(x)
def _sigmoid(x):
    return torch.sigmoid(x)
def _layernorm(x, axis=-1, eps=1e-5):
    m = x.mean(dim=axis, keepdim=True)
    v = x.var(dim=axis, keepdim=True, unbiased=False)
    return (x - m) / torch.sqrt(v + eps)
def _scatter_add(tgt, idx, src, axis=0):
    return tgt.clone().index_add_(axis, idx, src)
def _segment_sum(src, seg, n):
    out = torch.zeros((n,) + src.shape[1:], dtype=src.dtype)
    return out.index_add_(0, seg, src)
def _pad(x, pw):
    flat = tuple(v for pair in reversed(pw) for v in pair)
    return torch.nn.functional.pad(x, flat)

kernel_name = 'standalone__moe_arch_mod__prompt'

def setup_inputs():

    _w = (lambda a: (lambda t: t.to(torch.bfloat16) if t.is_floating_point() else t)(torch.as_tensor(a)))
    B, S, D, F, C = 1, 2048, 576, 4608, 2
    return {
        "x": _w((lambda *s: torch.randn(*s, dtype=torch.bfloat16) * 0.1)(B, S, D)),
        "w_r": _w((lambda *s: torch.randn(*s, dtype=torch.bfloat16) * 0.1)(D)),
        "w_gate": _w((lambda *s: torch.randn(*s, dtype=torch.bfloat16) * 0.1)(D, F)),
        "w_up": _w((lambda *s: torch.randn(*s, dtype=torch.bfloat16) * 0.1)(D, F)),
        "w_down": _w((lambda *s: torch.randn(*s, dtype=torch.bfloat16) * 0.1)(F, D)),
    }

def reference(x, w_r, w_gate, w_up, w_down):
    B, S, D = x.shape
    C = 2
    r = x @ w_r
    idx = torch.argsort(-r, axis=-1)[:, :C]
    idx_e = (lambda x, n, axis: torch.repeat_interleave(x, n, dim=axis))(idx.reshape(B, C, 1), D, axis=2)
    x_sel = (lambda x, i, axis: torch.take_along_dim(x, i, dim=axis))(x, idx_e, axis=1)
    g = _silu(x_sel @ w_gate)
    u = x_sel @ w_up
    y = (g * u) @ w_down
    r_sel = _sigmoid((lambda x, i, axis: torch.take_along_dim(x, i, dim=axis))(r, idx, axis=1))
    y = y * r_sel.reshape(B, C, 1)
    b_off = (torch.arange(B) * S).reshape(B, 1)
    flat_idx = (idx + b_off).reshape(B * C)
    zero = (x * 0.0).reshape(B * S, D)
    upd = _scatter_add(zero, flat_idx, y.reshape(B * C, D), axis=0)
    return x + upd.reshape(B, S, D)
```

```asm
; @launch grid=(256,1,1) block=(320,1,1) lds=83968
.amdgcn_target "amdgcn-amd-amdhsa--gfx950"
.text
.globl standalone__moe_arch_mod__prompt_kernel
.p2align 8
.type standalone__moe_arch_mod__prompt_kernel,@function
standalone__moe_arch_mod__prompt_kernel:
  s_load_dwordx2 s[4:5], s[0:1], 0
  s_load_dwordx2 s[8:9], s[0:1], 8
  s_load_dwordx2 s[16:17], s[0:1], 56
  s_load_dwordx4 s[24:27], s[0:1], 16
  s_load_dwordx2 s[12:13], s[0:1], 32
  s_load_dwordx2 s[20:21], s[0:1], 40
  s_getpc_b64 s[28:29]
L_PC:
  v_lshlrev_b32 v2, 7, v0
  v_cmp_gt_u32 vcc, (L_CODE_END-L_PC+127)/128, v0
  s_and_saveexec_b64 s[30:31], vcc
  s_cbranch_execz L_NOPF
  global_load_dword v196, v2, s[28:29]
L_NOPF:
  s_mov_b64 exec, -1
  v_lshrrev_b32 v1, 6, v0
  v_and_b32 v0, 63, v0
  v_readfirstlane_b32 s3, v1
  s_cmp_ge_u32 s2, 256
  s_cbranch_scc1 L_END
  s_sub_u32 s3, s3, 1
  s_cselect_b32 s3, 4, s3
  s_mov_b32 s6, 2359296
  s_mov_b32 s7, 0x20000
  s_mov_b32 s11, 0x20000
  s_mov_b32 s14, 5308416
  s_mov_b32 s15, 0x20000
  s_mov_b32 s18, 1048576
  s_mov_b32 s19, 0x20000
  s_mov_b32 s22, 2359296
  s_mov_b32 s23, 0x20000
  s_cmp_lg_u32 s3, 4
  s_cbranch_scc1 L_NOTX
  s_setprio 3
  s_mov_b32 s10, 1152
  s_mov_b32 m0, 77824
  v_lshlrev_b32 v8, 4, v0
  v_and_b32 v1, 0x70, v8
  v_lshrrev_b32 v9, 3, v0
  v_mul_u32_u24 v10, 1152, v9
  v_add_u32 v10, v10, v1
  s_mul_i32 s28, s2, 9216
  s_waitcnt lgkmcnt(0)
  s_load_dword s47, s[16:17], 0
  buffer_load_dwordx4 v8, s[8:11], 0 offen lds
  s_mov_b64 exec, 0xff
  buffer_load_dwordx4 v8, s[8:11], 0 offen offset:1024 lds
  s_mov_b64 exec, -1
  buffer_load_dwordx4 v[84:87], v10, s[4:7], s28 offen offset:0
  buffer_load_dwordx4 v[88:91], v10, s[4:7], s28 offen offset:128
  buffer_load_dwordx4 v[92:95], v10, s[4:7], s28 offen offset:256
  buffer_load_dwordx4 v[96:99], v10, s[4:7], s28 offen offset:384
  buffer_load_dwordx4 v[100:103], v10, s[4:7], s28 offen offset:512
  buffer_load_dwordx4 v[104:107], v10, s[4:7], s28 offen offset:640
  buffer_load_dwordx4 v[108:111], v10, s[4:7], s28 offen offset:768
  buffer_load_dwordx4 v[112:115], v10, s[4:7], s28 offen offset:896
  buffer_load_dwordx4 v[116:119], v10, s[4:7], s28 offen offset:1024
  s_branch L_X2
L_NOTX:
  s_mov_b32 s10, 5308416
  s_cmp_ge_u32 s2, 144
  s_cbranch_scc1 L_HELP
  s_and_b32 s45, s2, 7
  s_mul_i32 s45, s45, 18
  s_lshr_b32 s44, s2, 3
  s_add_u32 s45, s45, s44
  v_and_b32 v2, 15, v0
  v_lshrrev_b32 v3, 4, v0
  v_mul_u32_u24 v4, 9216, v3
  v_lshl_add_u32 v4, v2, 4, v4
  s_mul_i32 s34, s45, 36864
  s_lshl_b32 s35, s3, 8
  s_add_u32 s34, s34, s35
  s_add_u32 s35, s34, 4608
  v_lshrrev_b32 v8, 2, v0
  v_mul_u32_u24 v8, 9216, v8
  v_lshrrev_b32 v9, 4, v0
  v_and_b32 v9, 2, v9
  v_xor_b32 v9, v9, v0
  v_and_b32 v9, 3, v9
  v_lshl_add_u32 v8, v9, 4, v8
  s_and_b32 s28, s3, 1
  s_mul_i32 s28, s28, 2654208
  s_lshl_b32 s29, s45, 6
  s_add_u32 s28, s28, s29
  s_and_b32 s42, s45, 1
  s_mul_i32 s29, s42, 589824
  s_add_u32 s46, s28, 1179648
  s_add_u32 s43, s28, 589824
  s_sub_u32 s43, s43, s29
  s_add_u32 s28, s28, s29
  s_mul_i32 s30, s3, 18432
  s_mov_b32 m0, s30
  s_cmp_ge_u32 s3, 2
  s_waitcnt lgkmcnt(0)
  s_cselect_b32 s8, s26, s24
  s_cselect_b32 s9, s27, s25
  buffer_load_dwordx4 v8, s[8:11], s28 offen lds
  s_addk_i32 m0, 0x400
  s_add_u32 s28, s28, 147456
  buffer_load_dwordx4 v8, s[8:11], s28 offen lds
  s_addk_i32 m0, 0x400
  s_add_u32 s28, s28, 147456
  buffer_load_dwordx4 v8, s[8:11], s28 offen lds
  s_addk_i32 m0, 0x400
  s_add_u32 s28, s28, 147456
  s_branch L_C2
L_HELP:
  s_sub_u32 s28, s2, 144
  s_and_b32 s29, s28, 7
  s_lshr_b32 s28, s28, 3
  s_and_b32 s33, s3, 1
  s_mul_i32 s33, s33, 288
  s_mul_i32 s32, s28, 4
  s_add_u32 s32, s32, s33
  s_add_u32 s32, s32, 128
  s_mul_i32 s32, s32, 9216
  s_mul_i32 s34, s29, 1152
  s_add_u32 s32, s32, s34
  v_mul_u32_u24 v3, 0x1c72, v0
  v_lshrrev_b32 v3, 16, v3
  v_mul_u32_u24 v4, 9, v3
  v_sub_u32 v4, v0, v4
  v_mul_u32_u24 v3, 9216, v3
  v_lshl_add_u32 v3, v4, 7, v3
  s_lshl2_add_u32 s28, s28, s3
  s_mul_i32 s29, s29, 663552
  v_lshlrev_b32 v2, 7, v0
  s_mov_b32 s30, 2
  s_cmp_ge_u32 s3, 2
  s_waitcnt lgkmcnt(0)
  s_cselect_b32 s8, s26, s24
  s_cselect_b32 s9, s27, s25
  s_bfm_b64 exec, 36, 0
  buffer_load_dword v197, v3, s[8:11], s32 offen
  s_add_u32 s32, s32, 516096
  s_barrier
L_HGL:
  s_waitcnt vmcnt(2)
  buffer_load_dword v197, v3, s[8:11], s32 offen
  s_add_u32 s32, s32, 516096
  s_sub_u32 s30, s30, 1
  s_cmp_lg_u32 s30, 0
  s_cbranch_scc1 L_HGL
  s_bfm_b64 exec, 32, 0
L_HWL:
  s_mul_hi_u32 s35, s28, 477218589
  s_mul_i32 s31, s35, 9
  s_sub_u32 s31, s28, s31
  s_mul_i32 s35, s35, 36864
  s_lshl_b32 s31, s31, 12
  s_add_u32 s35, s35, s31
  s_add_u32 s35, s35, s29
  buffer_load_dword v197, v2, s[12:15], s35 offen
  s_add_u32 s28, s28, 56
  s_cmp_lt_u32 s28, 162
  s_cbranch_scc1 L_HWL
  s_waitcnt vmcnt(0)
  s_barrier
  s_branch L_FIN
L_X2:
  v_add_u32 v1, 77824, v1
  s_lshl_b32 s29, s2, 3
  s_sub_u32 s29, 2047, s29
  v_sub_u32 v11, s29, v9
  s_mov_b32 s30, 0xffff0000
  s_and_b32 s29, s2, 3
  s_mul_i32 s27, s29, 16384
  s_add_u32 s27, s27, 4096
  s_add_u32 s48, s27, 4096
  s_add_u32 s49, s27, 8192
  s_add_u32 s50, s27, 12288
  s_and_b32 s29, s2, 7
  s_lshl_b32 s29, s29, 5
  s_lshr_b32 s31, s2, 3
  s_add_u32 s29, s29, s31
  s_mul_i32 s29, s29, 64
  s_add_u32 s31, s29, 4096
  v_mul_u32_u24 v44, 64, v0
  v_mov_b32 v12, 0
  v_mov_b32 v13, 0
  v_mov_b32 v14, 0
  v_mov_b32 v15, 0
  v_bfrev_b32 v22, 1
  v_bfe_u32 v21, v0, 2, 2
  v_mul_u32_u24 v21, 16384, v21
  v_and_b32 v19, 3, v0
  v_lshl_add_u32 v21, v19, 4, v21
  s_mov_b32 s61, 200000
  v_mov_b32 v45, 76032
  s_waitcnt vmcnt(9) lgkmcnt(0)
  ds_read_b128 v[48:51], v1 offset:0
  ds_read_b128 v[52:55], v1 offset:128
  ds_read_b128 v[56:59], v1 offset:256
  ds_read_b128 v[60:63], v1 offset:384
  ds_read_b128 v[64:67], v1 offset:512
  ds_read_b128 v[68:71], v1 offset:640
  ds_read_b128 v[72:75], v1 offset:768
  ds_read_b128 v[76:79], v1 offset:896
  ds_read_b128 v[80:83], v1 offset:1024
  s_add_u32 s47, s47, 0x01010101
  v_mov_b32 v18, s47
  s_waitcnt vmcnt(8) lgkmcnt(8)
  v_dot2c_f32_bf16 v12, v84, v48
  v_dot2c_f32_bf16 v13, v85, v49
  v_dot2c_f32_bf16 v14, v86, v50
  v_dot2c_f32_bf16 v15, v87, v51
  s_waitcnt vmcnt(7) lgkmcnt(7)
  v_dot2c_f32_bf16 v12, v88, v52
  v_dot2c_f32_bf16 v13, v89, v53
  v_dot2c_f32_bf16 v14, v90, v54
  v_dot2c_f32_bf16 v15, v91, v55
  s_waitcnt vmcnt(6) lgkmcnt(6)
  v_dot2c_f32_bf16 v12, v92, v56
  v_dot2c_f32_bf16 v13, v93, v57
  v_dot2c_f32_bf16 v14, v94, v58
  v_dot2c_f32_bf16 v15, v95, v59
  s_waitcnt vmcnt(5) lgkmcnt(5)
  v_dot2c_f32_bf16 v12, v96, v60
  v_dot2c_f32_bf16 v13, v97, v61
  v_dot2c_f32_bf16 v14, v98, v62
  v_dot2c_f32_bf16 v15, v99, v63
  s_waitcnt vmcnt(4) lgkmcnt(4)
  v_dot2c_f32_bf16 v12, v100, v64
  v_dot2c_f32_bf16 v13, v101, v65
  v_dot2c_f32_bf16 v14, v102, v66
  v_dot2c_f32_bf16 v15, v103, v67
  s_waitcnt vmcnt(3) lgkmcnt(3)
  v_dot2c_f32_bf16 v12, v104, v68
  v_dot2c_f32_bf16 v13, v105, v69
  v_dot2c_f32_bf16 v14, v106, v70
  v_dot2c_f32_bf16 v15, v107, v71
  s_waitcnt vmcnt(2) lgkmcnt(2)
  v_dot2c_f32_bf16 v12, v108, v72
  v_dot2c_f32_bf16 v13, v109, v73
  v_dot2c_f32_bf16 v14, v110, v74
  v_dot2c_f32_bf16 v15, v111, v75
  s_waitcnt vmcnt(1) lgkmcnt(1)
  v_dot2c_f32_bf16 v12, v112, v76
  v_dot2c_f32_bf16 v13, v113, v77
  v_dot2c_f32_bf16 v14, v114, v78
  v_dot2c_f32_bf16 v15, v115, v79
  s_waitcnt vmcnt(0) lgkmcnt(0)
  v_dot2c_f32_bf16 v12, v116, v80
  v_dot2c_f32_bf16 v13, v117, v81
  v_dot2c_f32_bf16 v14, v118, v82
  v_dot2c_f32_bf16 v15, v119, v83
  s_nop 1
  v_add_f32 v12, v12, v13
  v_add_f32 v14, v14, v15
  v_add_f32 v12, v12, v14
  s_movk_i32 s29, 0x207
  v_cmp_class_f32 s[96:97], v12, s29
  v_add_f32_dpp v12, v12, v12 quad_perm:[1,0,3,2] row_mask:0xf bank_mask:0xf
  s_nop 1
  v_add_f32_dpp v12, v12, v12 quad_perm:[2,3,0,1] row_mask:0xf bank_mask:0xf
  s_nop 1
  v_add_f32_dpp v12, v12, v12 row_half_mirror row_mask:0xf bank_mask:0xf
  v_cvt_pk_bf16_f32 v13, v12, v12
  v_cmp_u_f32 vcc, v12, v12
  v_ashrrev_i32 v14, 31, v13
  v_bitop3_b32 v13, v13, v14, v22 bitop3:0x1e
  v_cndmask_b32 v13, v13, 0, vcc
  v_and_or_b32 v13, v13, s30, v11
  s_nop 1
  v_max_u32_dpp v16, v13, v13 row_ror:8 row_mask:0xf bank_mask:0xf
  v_min_u32_dpp v17, v13, v13 row_ror:8 row_mask:0xf bank_mask:0xf
  s_nop 0
  v_min_u32_dpp v14, v16, v16 row_bcast:15 row_mask:0xa bank_mask:0xf
  v_max_u32_dpp v16, v16, v16 row_bcast:15 row_mask:0xa bank_mask:0xf
  v_max_u32_dpp v15, v17, v17 row_bcast:15 row_mask:0xa bank_mask:0xf
  v_max_u32 v17, v14, v15
  v_min_u32_dpp v14, v16, v16 row_bcast:31 row_mask:0xc bank_mask:0xf
  v_max_u32_dpp v16, v16, v16 row_bcast:31 row_mask:0xc bank_mask:0xf
  v_max_u32_dpp v15, v17, v17 row_bcast:31 row_mask:0xc bank_mask:0xf
  v_max_u32 v17, v14, v15
  s_lshl_b64 exec, 0xffff, 48
  buffer_store_dwordx4 v[16:19], v21, s[16:19], s31 offen sc1
  s_cmp_lt_u32 s2, 144
  s_cbranch_scc1 L_XG
  s_barrier
L_XG:
  ds_write_b32 v45, v18
  s_mov_b64 exec, -1
  s_and_b32 s45, s2, 7
  s_mul_i32 s45, s45, 18
  s_lshr_b32 s44, s2, 3
  s_add_u32 s45, s45, s44
  v_and_b32 v2, 15, v0
  v_lshrrev_b32 v3, 4, v0
  v_mul_u32_u24 v4, 9216, v3
  v_lshl_add_u32 v4, v2, 4, v4
  s_mul_i32 s34, s45, 36864
  s_lshl_b32 s35, s3, 8
  s_add_u32 s34, s34, s35
  s_add_u32 s35, s34, 4608
  v_lshrrev_b32 v5, 2, v2
  v_lshl_add_u32 v5, v3, 3, v5
  v_and_b32 v6, 1, v0
  v_lshl_add_u32 v5, v6, 2, v5
  v_lshlrev_b32 v5, 3, v5
  v_and_b32 v6, 2, v0
  v_lshl_add_u32 v5, v6, 1, v5
  v_add_u32 v5, 76800, v5
  v_and_b32 v6, 1, v0
  v_cmp_eq_u32 vcc, 1, v6
  v_mov_b32 v6, 0xffff
  v_mov_b32 v7, 0xffff0000
  v_cndmask_b32 v6, v6, v7, vcc
  v_lshlrev_b32 v7, 6, v2
  v_lshl_add_u32 v7, v3, 4, v7
  s_mul_i32 s36, s45, 4608
  s_lshl_b32 s37, s3, 10
  s_add_u32 s36, s36, s37
  s_add_u32 s36, s36, 69632
  v_mov_b32 v194, 76032
  s_mov_b32 s56, 0x07060501
  s_mov_b32 s57, 0x07060502
  s_mov_b32 s58, 0x07060503
  v_mov_b64 v[160:161], 0
  v_mov_b64 v[162:163], 0
  v_mov_b64 v[164:165], 0
  v_mov_b64 v[166:167], 0
  v_mov_b64 v[168:169], 0
  v_mov_b64 v[170:171], 0
  v_mov_b64 v[172:173], 0
  v_mov_b64 v[174:175], 0
  v_mov_b64 v[176:177], 0
  v_mov_b64 v[178:179], 0
  v_mov_b64 v[180:181], 0
  v_mov_b64 v[182:183], 0
  v_mov_b64 v[184:185], 0
  v_mov_b64 v[186:187], 0
  v_mov_b64 v[188:189], 0
  v_mov_b64 v[190:191], 0
  s_cmp_ge_u32 s2, 144
  s_cbranch_scc1 L_XH
  s_mov_b32 exec_lo, 0x00ff00ff
  s_mov_b32 exec_hi, 0x00ff00ff
  buffer_load_dwordx4 v[128:131], v4, s[12:15], s34 offen offset:0
  buffer_load_dwordx4 v[132:135], v4, s[12:15], s34 offen offset:1152
  buffer_load_dwordx4 v[136:139], v4, s[12:15], s34 offen offset:2304
  buffer_load_dwordx4 v[140:143], v4, s[12:15], s34 offen offset:3456
  buffer_load_dwordx4 v[144:147], v4, s[12:15], s35 offen offset:0
  buffer_load_dwordx4 v[148:151], v4, s[12:15], s35 offen offset:1152
  buffer_load_dwordx4 v[152:155], v4, s[12:15], s35 offen offset:2304
  buffer_load_dwordx4 v[156:159], v4, s[12:15], s35 offen offset:3456
  s_mov_b64 exec, -1
  s_waitcnt vmcnt(0)
L_P1:
  buffer_load_dwordx4 v[48:51], v44, s[16:19], s27 offen sc1
  buffer_load_dwordx4 v[52:55], v44, s[16:19], s48 offen sc1
  buffer_load_dwordx4 v[56:59], v44, s[16:19], s49 offen sc1
  buffer_load_dwordx4 v[60:63], v44, s[16:19], s50 offen sc1
  s_waitcnt vmcnt(0)
  v_cmp_ne_u32 vcc, s47, v50
  v_cmp_ne_u32 s[32:33], s47, v54
  v_cmp_ne_u32 s[38:39], s47, v58
  v_cmp_ne_u32 s[40:41], s47, v62
  s_or_b64 vcc, vcc, s[32:33]
  s_or_b64 s[38:39], s[38:39], s[40:41]
  s_or_b64 vcc, vcc, s[38:39]
  s_cbranch_scc0 L_PT
  s_sleep 2
  s_sub_u32 s61, s61, 1
  s_cbranch_scc0 L_P1
  .p2align 3
L_PT:
  v_min_u32 v12, v48, v52
  v_max_u32 v40, v48, v52
  v_max3_u32 v41, v12, v49, v53
  v_min_u32 v13, v56, v60
  v_max_u32 v42, v56, v60
  v_max3_u32 v43, v13, v57, v61
  v_min_u32 v12, v40, v42
  v_max_u32 v40, v40, v42
  v_max3_u32 v41, v12, v41, v43
  s_nop 0
  v_min_u32_dpp v12, v40, v40 quad_perm:[1,0,3,2] row_mask:0xf bank_mask:0xf
  v_max_u32_dpp v40, v40, v40 quad_perm:[1,0,3,2] row_mask:0xf bank_mask:0xf
  v_max_u32_dpp v13, v41, v41 quad_perm:[1,0,3,2] row_mask:0xf bank_mask:0xf
  v_max_u32 v41, v12, v13
  v_min_u32_dpp v12, v40, v40 quad_perm:[2,3,0,1] row_mask:0xf bank_mask:0xf
  v_max_u32_dpp v40, v40, v40 quad_perm:[2,3,0,1] row_mask:0xf bank_mask:0xf
  v_max_u32_dpp v13, v41, v41 quad_perm:[2,3,0,1] row_mask:0xf bank_mask:0xf
  v_max_u32 v41, v12, v13
  v_min_u32_dpp v12, v40, v40 row_ror:4 row_mask:0xf bank_mask:0xf
  v_max_u32_dpp v40, v40, v40 row_ror:4 row_mask:0xf bank_mask:0xf
  v_max_u32_dpp v13, v41, v41 row_ror:4 row_mask:0xf bank_mask:0xf
  v_max_u32 v41, v12, v13
  v_min_u32_dpp v12, v40, v40 row_ror:8 row_mask:0xf bank_mask:0xf
  v_max_u32_dpp v40, v40, v40 row_ror:8 row_mask:0xf bank_mask:0xf
  v_max_u32_dpp v13, v41, v41 row_ror:8 row_mask:0xf bank_mask:0xf
  v_max_u32 v41, v12, v13
  v_min_u32_dpp v12, v40, v40 row_bcast:15 row_mask:0xa bank_mask:0xf
  v_max_u32_dpp v40, v40, v40 row_bcast:15 row_mask:0xa bank_mask:0xf
  v_max_u32_dpp v13, v41, v41 row_bcast:15 row_mask:0xa bank_mask:0xf
  v_max_u32 v41, v12, v13
  v_min_u32_dpp v12, v40, v40 row_bcast:31 row_mask:0xc bank_mask:0xf
  v_max_u32_dpp v40, v40, v40 row_bcast:31 row_mask:0xc bank_mask:0xf
  v_max_u32_dpp v13, v41, v41 row_bcast:31 row_mask:0xc bank_mask:0xf
  v_max_u32 v41, v12, v13
  v_cmp_gt_u32 vcc, 8, v0
  v_readlane_b32 s32, v40, 63
  v_readlane_b32 s33, v41, 63
  s_cmp_ge_u32 s2, 144
  s_cbranch_scc1 L_XH2
  s_and_b32 s38, s32, 0x7ff
  s_and_b32 s39, s33, 0x7ff
  s_sub_u32 s38, 2047, s38
  s_sub_u32 s39, 2047, s39
  s_mul_i32 s38, s38, 1152
  s_mul_i32 s39, s39, 1152
  s_mov_b32 m0, 73728
  s_sub_u32 s40, s39, 128
  buffer_load_dwordx4 v8, s[4:7], s38 offen lds
  s_add_u32 s41, s38, 1024
  v_mov_b32 v12, s40
  v_mov_b32 v13, s41
  s_addk_i32 m0, 0x400
  v_cndmask_b32 v12, v12, v13, vcc
  v_add_u32 v12, v12, v8
  buffer_load_dwordx4 v12, s[4:7], 0 offen lds
  s_addk_i32 m0, 0x400
  s_add_u32 s40, s39, 896
  s_mov_b64 exec, 0xffff
  buffer_load_dwordx4 v8, s[4:7], s40 offen lds
  s_mov_b64 exec, -1
  s_barrier
  v_cmp_gt_u32 vcc, 32, v0
  v_mov_b32 v28, s33
  v_mov_b32 v29, s32
  v_and_b32 v31, 3, v0
  v_cndmask_b32 v28, v28, v29, vcc
  v_and_b32 v29, 0xffff, v28
  v_sub_u32 v29, 2047, v29
  v_mul_u32_u24 v29, 1152, v29
  v_bfe_u32 v30, v0, 4, 1
  v_lshlrev_b32 v30, 1, v30
  v_lshl_add_u32 v30, v31, 2, v30
  v_add_u32 v29, v29, v30
  v_not_b32 v32, v28
  v_ashrrev_i32 v32, 31, v32
  v_or_b32 v32, 0x80000000, v32
  v_xor_b32 v32, v32, v28
  v_and_b32 v32, 0xffff0000, v32
  v_mul_f32 v32, 0xbfb8aa3b, v32
  v_exp_f32 v32, v32
  v_lshrrev_b32 v33, 5, v0
  v_add_f32 v32, 1.0, v32
  v_rcp_f32 v32, v32
  v_mul_u32_u24 v33, 1152, v33
  v_cvt_pk_bf16_f32 v32, v32, v32
  v_and_b32 v32, 0xffff0000, v32
  s_sub_u32 s46, s45, 72
  s_lshl_b32 s50, s46, 4
  s_add_u32 s51, s50, 73728
  v_add3_u32 v33, v33, v30, s51
  v_lshrrev_b32 v34, 2, v0
  v_mul_u32_u24 v34, 4608, v34
  v_lshl_add_u32 v34, v31, 4, v34
  s_lshl_b32 s80, s46, 6
  s_add_u32 s80, s80, 69632
  s_add_u32 s81, s80, 73728
  s_add_u32 s82, s80, 147456
  s_add_u32 s83, s80, 221184
  s_add_u32 s84, s80, 294912
  s_add_u32 s85, s80, 368640
  s_add_u32 s86, s80, 442368
  s_add_u32 s87, s80, 516096
  s_add_u32 s88, s80, 589824
  s_mov_b32 s41, 0x0c04000c
  s_mov_b32 s42, 0x04020100
  v_mov_b32 v35, 0
  s_waitcnt vmcnt(0) lgkmcnt(0)
  s_barrier
  s_setprio 0
  s_branch L_JOIN
L_XH:
  s_barrier
  s_branch L_P1
L_XH2:
  s_and_b32 s38, s32, 0xffff
  s_and_b32 s39, s33, 0xffff
  v_cmp_ne_u32 s[52:53], s38, v11
  v_cmp_ne_u32 s[54:55], s39, v11
  s_and_b64 exec, s[52:53], s[54:55]
  s_cmp_lg_u64 s[96:97], 0
  s_cbranch_scc1 L_FIX1
L_FIXR1:
  buffer_store_dwordx4 v[84:87], v10, s[20:23], s28 offen offset:0 sc1
  buffer_store_dwordx4 v[88:91], v10, s[20:23], s28 offen offset:128 sc1
  buffer_store_dwordx4 v[92:95], v10, s[20:23], s28 offen offset:256 sc1
  buffer_store_dwordx4 v[96:99], v10, s[20:23], s28 offen offset:384 sc1
  buffer_store_dwordx4 v[100:103], v10, s[20:23], s28 offen offset:512 sc1
  buffer_store_dwordx4 v[104:107], v10, s[20:23], s28 offen offset:640 sc1
  buffer_store_dwordx4 v[108:111], v10, s[20:23], s28 offen offset:768 sc1
  buffer_store_dwordx4 v[112:115], v10, s[20:23], s28 offen offset:896 sc1
  buffer_store_dwordx4 v[116:119], v10, s[20:23], s28 offen offset:1024 sc1
  s_branch L_FIN
L_C2:
  v_lshrrev_b32 v5, 2, v2
  v_lshl_add_u32 v5, v3, 3, v5
  v_and_b32 v6, 1, v0
  v_lshl_add_u32 v5, v6, 2, v5
  v_lshlrev_b32 v5, 3, v5
  v_and_b32 v6, 2, v0
  v_lshl_add_u32 v5, v6, 1, v5
  v_add_u32 v5, 76800, v5
  v_and_b32 v6, 1, v0
  v_cmp_eq_u32 vcc, 1, v6
  v_mov_b32 v6, 0xffff
  v_mov_b32 v7, 0xffff0000
  v_cndmask_b32 v6, v6, v7, vcc
  v_lshlrev_b32 v7, 6, v2
  v_lshl_add_u32 v7, v3, 4, v7
  s_mul_i32 s36, s45, 4608
  s_lshl_b32 s37, s3, 10
  s_add_u32 s36, s36, s37
  s_add_u32 s36, s36, 69632
  v_mov_b32 v194, 76032
  s_mov_b32 s56, 0x07060501
  s_mov_b32 s57, 0x07060502
  s_mov_b32 s58, 0x07060503
  v_mov_b64 v[160:161], 0
  v_mov_b64 v[162:163], 0
  v_mov_b64 v[164:165], 0
  v_mov_b64 v[166:167], 0
  v_mov_b64 v[168:169], 0
  v_mov_b64 v[170:171], 0
  v_mov_b64 v[172:173], 0
  v_mov_b64 v[174:175], 0
  v_mov_b64 v[176:177], 0
  v_mov_b64 v[178:179], 0
  v_mov_b64 v[180:181], 0
  v_mov_b64 v[182:183], 0
  v_mov_b64 v[184:185], 0
  v_mov_b64 v[186:187], 0
  v_mov_b64 v[188:189], 0
  v_mov_b64 v[190:191], 0
  v_lshlrev_b32 v9, 9, v3
  v_bfe_u32 v10, v0, 2, 2
  v_lshl_add_u32 v9, v10, 6, v9
  v_and_b32 v10, 3, v0
  v_lshl_add_u32 v9, v10, 3, v9
  v_and_b32 v10, 1, v3
  v_lshl_add_u32 v9, v10, 5, v9
  v_add_u32 v9, s30, v9
  v_xor_b32 v10, 32, v9
  v_and_b32 v11, 1, v0
  v_mul_u32_u24 v11, 1152, v11
  v_lshl_add_u32 v11, v3, 4, v11
  s_and_b32 s29, s3, 1
  s_mul_i32 s29, s29, 576
  s_add_u32 s29, s29, 73728
  s_mul_i32 s31, s42, 128
  v_add_u32 v193, s29, v11
  v_add_u32 v11, s31, v193
  v_subrev_u32 v1, s31, v193
  s_lshl_b32 s29, s3, 8
  s_add_u32 s29, s29, 76800
  v_lshl_add_u32 v192, v2, 3, s29
  s_waitcnt vmcnt(2)
  buffer_load_dwordx4 v8, s[8:11], s28 offen lds
  s_addk_i32 m0, 0x400
  s_add_u32 s28, s28, 147456
  s_waitcnt vmcnt(2)
  ds_read_b64_tr_b16 v[48:49], v9 offset:0
  ds_read_b64_tr_b16 v[50:51], v9 offset:256
  ds_read_b64_tr_b16 v[52:53], v10 offset:0
  ds_read_b64_tr_b16 v[54:55], v10 offset:256
  s_waitcnt vmcnt(0)
  s_mov_b32 s28, s43
  buffer_load_dwordx4 v8, s[8:11], s28 offen lds
  s_addk_i32 m0, 0x400
  s_add_u32 s28, s28, 147456
  buffer_load_dwordx4 v8, s[8:11], s28 offen lds
  s_addk_i32 m0, 0x400
  s_add_u32 s28, s28, 147456
  buffer_load_dwordx4 v8, s[8:11], s28 offen lds
  s_addk_i32 m0, 0x400
  s_add_u32 s28, s28, 147456
  buffer_load_dwordx4 v8, s[8:11], s28 offen lds
  s_addk_i32 m0, 0x400
  s_add_u32 s28, s28, 147456
  ds_read_b64_tr_b16 v[56:57], v9 offset:2048
  ds_read_b64_tr_b16 v[58:59], v9 offset:2304
  ds_read_b64_tr_b16 v[60:61], v10 offset:2048
  ds_read_b64_tr_b16 v[62:63], v10 offset:2304
  s_waitcnt vmcnt(3)
  s_mov_b32 s28, s46
  buffer_load_dwordx4 v8, s[8:11], s28 offen lds
  s_addk_i32 m0, 0x400
  s_add_u32 s28, s28, 147456
  s_waitcnt vmcnt(3)
  buffer_load_dwordx4 v8, s[8:11], s28 offen lds
  s_addk_i32 m0, 0x400
  s_add_u32 s28, s28, 147456
  ds_read_b64_tr_b16 v[64:65], v9 offset:4096
  ds_read_b64_tr_b16 v[66:67], v9 offset:4352
  ds_read_b64_tr_b16 v[68:69], v10 offset:4096
  ds_read_b64_tr_b16 v[70:71], v10 offset:4352
  s_waitcnt vmcnt(3)
  buffer_load_dwordx4 v8, s[8:11], s28 offen lds
  s_addk_i32 m0, 0x400
  s_add_u32 s28, s28, 147456
  s_waitcnt vmcnt(3)
  buffer_load_dwordx4 v8, s[8:11], s28 offen lds
  s_addk_i32 m0, 0x400
  s_add_u32 s28, s28, 147456
  ds_read_b64_tr_b16 v[72:73], v9 offset:6144
  ds_read_b64_tr_b16 v[74:75], v9 offset:6400
  ds_read_b64_tr_b16 v[76:77], v10 offset:6144
  ds_read_b64_tr_b16 v[78:79], v10 offset:6400
  s_waitcnt vmcnt(3)
  buffer_load_dwordx4 v8, s[8:11], s28 offen lds
  s_addk_i32 m0, 0x400
  s_add_u32 s28, s28, 147456
  s_waitcnt vmcnt(3)
  buffer_load_dwordx4 v8, s[8:11], s28 offen lds
  s_addk_i32 m0, 0x400
  s_add_u32 s28, s28, 147456
  ds_read_b64_tr_b16 v[80:81], v9 offset:8192
  ds_read_b64_tr_b16 v[82:83], v9 offset:8448
  ds_read_b64_tr_b16 v[84:85], v10 offset:8192
  ds_read_b64_tr_b16 v[86:87], v10 offset:8448
  s_waitcnt vmcnt(3)
  buffer_load_dwordx4 v8, s[8:11], s28 offen lds
  s_addk_i32 m0, 0x400
  s_add_u32 s28, s28, 147456
  s_waitcnt vmcnt(3)
  buffer_load_dwordx4 v8, s[8:11], s28 offen lds
  s_addk_i32 m0, 0x400
  s_add_u32 s28, s28, 147456
  ds_read_b64_tr_b16 v[88:89], v9 offset:10240
  ds_read_b64_tr_b16 v[90:91], v9 offset:10496
  ds_read_b64_tr_b16 v[92:93], v10 offset:10240
  ds_read_b64_tr_b16 v[94:95], v10 offset:10496
  s_waitcnt vmcnt(3)
  buffer_load_dwordx4 v8, s[8:11], s28 offen lds
  s_addk_i32 m0, 0x400
  s_add_u32 s28, s28, 147456
  s_waitcnt vmcnt(3)
  buffer_load_dwordx4 v8, s[8:11], s28 offen lds
  ds_read_b64_tr_b16 v[96:97], v9 offset:12288
  ds_read_b64_tr_b16 v[98:99], v9 offset:12544
  ds_read_b64_tr_b16 v[100:101], v10 offset:12288
  ds_read_b64_tr_b16 v[102:103], v10 offset:12544
  s_barrier
  buffer_load_dwordx4 v[128:131], v4, s[12:15], s34 offen offset:0
  buffer_load_dwordx4 v[132:135], v4, s[12:15], s34 offen offset:1152
  buffer_load_dwordx4 v[136:139], v4, s[12:15], s34 offen offset:2304
  buffer_load_dwordx4 v[140:143], v4, s[12:15], s34 offen offset:3456
  buffer_load_dwordx4 v[144:147], v4, s[12:15], s35 offen offset:0
  buffer_load_dwordx4 v[148:151], v4, s[12:15], s35 offen offset:1152
  buffer_load_dwordx4 v[152:155], v4, s[12:15], s35 offen offset:2304
  buffer_load_dwordx4 v[156:159], v4, s[12:15], s35 offen offset:3456
  s_waitcnt lgkmcnt(0)
  s_barrier
  ds_read_b128 v[12:15], v11 offset:0
  ds_read_b128 v[16:19], v11 offset:64
  ds_read_b128 v[20:23], v1 offset:128
  ds_read_b128 v[24:27], v1 offset:192
  ds_read_b128 v[28:31], v193 offset:256
  ds_read_b128 v[32:35], v193 offset:320
  ds_read_b128 v[36:39], v193 offset:384
  ds_read_b128 v[40:43], v193 offset:448
  ds_read_b128 v[44:47], v193 offset:512
  s_waitcnt lgkmcnt(8)
  v_mfma_f32_16x16x32_bf16 v[120:123], v[12:15], v[48:51], 0
  v_mfma_f32_16x16x32_bf16 v[124:127], v[12:15], v[52:55], 0
  s_waitcnt lgkmcnt(7)
  v_mfma_f32_16x16x32_bf16 v[120:123], v[16:19], v[56:59], v[120:123]
  v_mfma_f32_16x16x32_bf16 v[124:127], v[16:19], v[60:63], v[124:127]
  s_waitcnt lgkmcnt(6)
  v_mfma_f32_16x16x32_bf16 v[120:123], v[20:23], v[64:67], v[120:123]
  v_mfma_f32_16x16x32_bf16 v[124:127], v[20:23], v[68:71], v[124:127]
  s_waitcnt lgkmcnt(5)
  v_mfma_f32_16x16x32_bf16 v[120:123], v[24:27], v[72:75], v[120:123]
  v_mfma_f32_16x16x32_bf16 v[124:127], v[24:27], v[76:79], v[124:127]
  s_waitcnt lgkmcnt(4)
  v_mfma_f32_16x16x32_bf16 v[120:123], v[28:31], v[80:83], v[120:123]
  v_mfma_f32_16x16x32_bf16 v[124:127], v[28:31], v[84:87], v[124:127]
  s_waitcnt lgkmcnt(3)
  v_mfma_f32_16x16x32_bf16 v[120:123], v[32:35], v[88:91], v[120:123]
  v_mfma_f32_16x16x32_bf16 v[124:127], v[32:35], v[92:95], v[124:127]
  s_waitcnt vmcnt(10)
  ds_read_b64_tr_b16 v[104:105], v9 offset:14336
  ds_read_b64_tr_b16 v[106:107], v9 offset:14592
  ds_read_b64_tr_b16 v[108:109], v10 offset:14336
  ds_read_b64_tr_b16 v[110:111], v10 offset:14592
  s_waitcnt lgkmcnt(6)
  v_mfma_f32_16x16x32_bf16 v[120:123], v[36:39], v[96:99], v[120:123]
  v_mfma_f32_16x16x32_bf16 v[124:127], v[36:39], v[100:103], v[124:127]
  s_waitcnt vmcnt(8)
  ds_read_b64_tr_b16 v[112:113], v9 offset:16384
  ds_read_b64_tr_b16 v[114:115], v9 offset:16640
  ds_read_b64_tr_b16 v[116:117], v10 offset:16384
  ds_read_b64_tr_b16 v[118:119], v10 offset:16640
  s_waitcnt lgkmcnt(4)
  v_mfma_f32_16x16x32_bf16 v[120:123], v[40:43], v[104:107], v[120:123]
  v_mfma_f32_16x16x32_bf16 v[124:127], v[40:43], v[108:111], v[124:127]
  s_waitcnt lgkmcnt(0)
  v_mfma_f32_16x16x32_bf16 v[120:123], v[44:47], v[112:115], v[120:123]
  v_mfma_f32_16x16x32_bf16 v[124:127], v[44:47], v[116:119], v[124:127]
  s_mov_b64 exec, 0xffff
  s_nop 6
  ds_write2_b64 v192, v[120:121], v[124:125] offset0:0 offset1:16
  s_mov_b64 exec, -1
L_JOIN:
  s_waitcnt lgkmcnt(0)
  s_barrier
  ds_read2_b32 v[12:13], v5 offset0:0 offset1:64
  ds_read2_b32 v[14:15], v5 offset0:128 offset1:192
  ds_read_b32 v23, v194
  s_cmp_eq_u32 s3, 4
  s_waitcnt lgkmcnt(0)
  v_add_f32 v12, v12, v13
  v_add_f32 v14, v14, v15
  v_cvt_pk_bf16_f32 v12, v12, v14
  v_lshlrev_b32 v13, 16, v12
  v_mul_f32 v15, 0xbfb8aa3b, v13
  v_exp_f32 v15, v15
  v_and_b32 v14, 0xffff0000, v12
  v_add_f32 v15, 1.0, v15
  v_rcp_f32 v15, v15
  s_nop 0
  v_mul_f32 v13, v13, v15
  v_cvt_pk_bf16_f32 v13, v13, v13
  v_and_b32 v13, 0xffff0000, v13
  v_mul_f32 v13, v13, v14
  v_cvt_pk_bf16_f32 v13, v13, v13
  s_waitcnt vmcnt(0)
  s_nop 0
  v_and_b32_dpp v12, v13, v6 quad_perm:[0,0,2,2] row_mask:0xf bank_mask:0xf
  v_and_b32_dpp v16, v13, v6 quad_perm:[1,1,3,3] row_mask:0xf bank_mask:0xf
  s_nop 0
  .p2align 3
  v_mov_b32_dpp v160, v12 quad_perm:[0,1,2,3] row_mask:0xf bank_mask:0x1
  v_mov_b32_dpp v161, v12 row_ror:4 row_mask:0xf bank_mask:0x2
  v_mov_b32_dpp v162, v12 row_ror:8 row_mask:0xf bank_mask:0x4
  v_mov_b32_dpp v163, v12 row_ror:12 row_mask:0xf bank_mask:0x8
  v_mov_b32_dpp v164, v12 row_ror:12 row_mask:0xf bank_mask:0x1
  v_mov_b32_dpp v165, v12 quad_perm:[0,1,2,3] row_mask:0xf bank_mask:0x2
  v_mov_b32_dpp v166, v12 row_ror:4 row_mask:0xf bank_mask:0x4
  v_mov_b32_dpp v167, v12 row_ror:8 row_mask:0xf bank_mask:0x8
  v_mfma_f32_16x16x32_bf16 v[120:123], v[160:163], v[128:131], 0
  v_mov_b32_dpp v168, v12 row_ror:8 row_mask:0xf bank_mask:0x1
  v_mov_b32_dpp v169, v12 row_ror:12 row_mask:0xf bank_mask:0x2
  v_mov_b32_dpp v170, v12 quad_perm:[0,1,2,3] row_mask:0xf bank_mask:0x4
  v_mov_b32_dpp v171, v12 row_ror:4 row_mask:0xf bank_mask:0x8
  v_mfma_f32_16x16x32_bf16 v[120:123], v[164:167], v[132:135], v[120:123]
  v_mov_b32_dpp v172, v12 row_ror:4 row_mask:0xf bank_mask:0x1
  v_mov_b32_dpp v173, v12 row_ror:8 row_mask:0xf bank_mask:0x2
  v_mov_b32_dpp v174, v12 row_ror:12 row_mask:0xf bank_mask:0x4
  v_mov_b32_dpp v175, v12 quad_perm:[0,1,2,3] row_mask:0xf bank_mask:0x8
  v_mfma_f32_16x16x32_bf16 v[120:123], v[168:171], v[136:139], v[120:123]
  v_mov_b32_dpp v176, v16 quad_perm:[0,1,2,3] row_mask:0xf bank_mask:0x1
  v_mov_b32_dpp v177, v16 row_ror:4 row_mask:0xf bank_mask:0x2
  v_mov_b32_dpp v178, v16 row_ror:8 row_mask:0xf bank_mask:0x4
  v_mov_b32_dpp v179, v16 row_ror:12 row_mask:0xf bank_mask:0x8
  v_mfma_f32_16x16x32_bf16 v[120:123], v[172:175], v[140:143], v[120:123]
  v_mov_b32_dpp v180, v16 row_ror:12 row_mask:0xf bank_mask:0x1
  v_mov_b32_dpp v181, v16 quad_perm:[0,1,2,3] row_mask:0xf bank_mask:0x2
  v_mov_b32_dpp v182, v16 row_ror:4 row_mask:0xf bank_mask:0x4
  v_mov_b32_dpp v183, v16 row_ror:8 row_mask:0xf bank_mask:0x8
  v_mfma_f32_16x16x32_bf16 v[120:123], v[176:179], v[144:147], v[120:123]
  v_mov_b32_dpp v184, v16 row_ror:8 row_mask:0xf bank_mask:0x1
  v_mov_b32_dpp v185, v16 row_ror:12 row_mask:0xf bank_mask:0x2
  v_mov_b32_dpp v186, v16 quad_perm:[0,1,2,3] row_mask:0xf bank_mask:0x4
  v_mov_b32_dpp v187, v16 row_ror:4 row_mask:0xf bank_mask:0x8
  v_mfma_f32_16x16x32_bf16 v[120:123], v[180:183], v[148:151], v[120:123]
  v_mov_b32_dpp v188, v16 row_ror:4 row_mask:0xf bank_mask:0x1
  v_mov_b32_dpp v189, v16 row_ror:8 row_mask:0xf bank_mask:0x2
  v_mov_b32_dpp v190, v16 row_ror:12 row_mask:0xf bank_mask:0x4
  v_mov_b32_dpp v191, v16 quad_perm:[0,1,2,3] row_mask:0xf bank_mask:0x8
  v_mfma_f32_16x16x32_bf16 v[120:123], v[184:187], v[152:155], v[120:123]
  s_nop 0
  v_mfma_f32_16x16x32_bf16 v[120:123], v[188:191], v[156:159], v[120:123]
  s_cselect_b32 exec_lo, 0x00ff00ff, -1
  s_cselect_b32 exec_hi, 0x00ff00ff, -1
  s_nop 5
  v_perm_b32 v20, v120, v123, s56
  v_perm_b32 v21, v121, v123, s57
  v_perm_b32 v22, v122, v123, s58
  buffer_store_dwordx4 v[20:23], v7, s[16:19], s36 offen sc1
  s_cbranch_scc0 L_FIN
  s_barrier
  s_mov_b64 exec, -1
  s_and_b32 s38, s32, 0xffff
  s_and_b32 s39, s33, 0xffff
  v_cmp_ne_u32 s[52:53], s38, v11
  v_cmp_ne_u32 s[54:55], s39, v11
  s_and_b64 exec, s[52:53], s[54:55]
  s_cmp_lg_u64 s[96:97], 0
  s_cbranch_scc1 L_FIX2
L_FIXR2:
  buffer_store_dwordx4 v[84:87], v10, s[20:23], s28 offen offset:0 sc1
  buffer_store_dwordx4 v[88:91], v10, s[20:23], s28 offen offset:128 sc1
  buffer_store_dwordx4 v[92:95], v10, s[20:23], s28 offen offset:256 sc1
  buffer_store_dwordx4 v[96:99], v10, s[20:23], s28 offen offset:384 sc1
  buffer_store_dwordx4 v[100:103], v10, s[20:23], s28 offen offset:512 sc1
  buffer_store_dwordx4 v[104:107], v10, s[20:23], s28 offen offset:640 sc1
  buffer_store_dwordx4 v[108:111], v10, s[20:23], s28 offen offset:768 sc1
  buffer_store_dwordx4 v[112:115], v10, s[20:23], s28 offen offset:896 sc1
  buffer_store_dwordx4 v[116:119], v10, s[20:23], s28 offen offset:1024 sc1
  s_cmp_ge_u32 s46, 72
  s_cbranch_scc1 L_FIN
  s_mov_b64 exec, -1
  ds_read_u16_d16_hi v35, v33
  s_mov_b32 s61, 200000
  s_waitcnt vmcnt(0)
  buffer_load_dwordx4 v[48:51], v34, s[16:19], s80 offen sc1
  buffer_load_dwordx4 v[52:55], v34, s[16:19], s81 offen sc1
  buffer_load_dwordx4 v[56:59], v34, s[16:19], s82 offen sc1
  buffer_load_dwordx4 v[60:63], v34, s[16:19], s83 offen sc1
  buffer_load_dwordx4 v[64:67], v34, s[16:19], s84 offen sc1
  buffer_load_dwordx4 v[68:71], v34, s[16:19], s85 offen sc1
  buffer_load_dwordx4 v[72:75], v34, s[16:19], s86 offen sc1
  buffer_load_dwordx4 v[76:79], v34, s[16:19], s87 offen sc1
  buffer_load_dwordx4 v[80:83], v34, s[16:19], s88 offen sc1
L_R0:
  s_waitcnt vmcnt(8)
  v_cmp_ne_u32 vcc, s47, v51
  s_cbranch_vccnz L_RR0
L_RA0:
  v_perm_b32 v51, v49, v48, s41
  v_perm_b32 v51, v50, v51, s42
L_R1:
  s_waitcnt vmcnt(7)
  v_cmp_ne_u32 vcc, s47, v55
  s_cbranch_vccnz L_RR1
L_RA1:
  v_perm_b32 v55, v53, v52, s41
  v_perm_b32 v55, v54, v55, s42
  v_pk_add_f32 v[48:49], v[48:49], v[52:53]
  v_pk_add_f32 v[50:51], v[50:51], v[54:55]
L_R2:
  s_waitcnt vmcnt(6)
  v_cmp_ne_u32 vcc, s47, v59
  s_cbranch_vccnz L_RR2
L_RA2:
  v_perm_b32 v59, v57, v56, s41
  v_perm_b32 v59, v58, v59, s42
  v_pk_add_f32 v[48:49], v[48:49], v[56:57]
  v_pk_add_f32 v[50:51], v[50:51], v[58:59]
L_R3:
  s_waitcnt vmcnt(5)
  v_cmp_ne_u32 vcc, s47, v63
  s_cbranch_vccnz L_RR3
L_RA3:
  v_perm_b32 v63, v61, v60, s41
  v_perm_b32 v63, v62, v63, s42
  v_pk_add_f32 v[48:49], v[48:49], v[60:61]
  v_pk_add_f32 v[50:51], v[50:51], v[62:63]
L_R4:
  s_waitcnt vmcnt(4)
  v_cmp_ne_u32 vcc, s47, v67
  s_cbranch_vccnz L_RR4
L_RA4:
  v_perm_b32 v67, v65, v64, s41
  v_perm_b32 v67, v66, v67, s42
  v_pk_add_f32 v[48:49], v[48:49], v[64:65]
  v_pk_add_f32 v[50:51], v[50:51], v[66:67]
L_R5:
  s_waitcnt vmcnt(3)
  v_cmp_ne_u32 vcc, s47, v71
  s_cbranch_vccnz L_RR5
L_RA5:
  v_perm_b32 v71, v69, v68, s41
  v_perm_b32 v71, v70, v71, s42
  v_pk_add_f32 v[48:49], v[48:49], v[68:69]
  v_pk_add_f32 v[50:51], v[50:51], v[70:71]
L_R6:
  s_waitcnt vmcnt(2)
  v_cmp_ne_u32 vcc, s47, v75
  s_cbranch_vccnz L_RR6
L_RA6:
  v_perm_b32 v75, v73, v72, s41
  v_perm_b32 v75, v74, v75, s42
  v_pk_add_f32 v[48:49], v[48:49], v[72:73]
  v_pk_add_f32 v[50:51], v[50:51], v[74:75]
L_R7:
  s_waitcnt vmcnt(1)
  v_cmp_ne_u32 vcc, s47, v79
  s_cbranch_vccnz L_RR7
L_RA7:
  v_perm_b32 v79, v77, v76, s41
  v_perm_b32 v79, v78, v79, s42
  v_pk_add_f32 v[48:49], v[48:49], v[76:77]
  v_pk_add_f32 v[50:51], v[50:51], v[78:79]
L_R8:
  s_waitcnt vmcnt(0)
  v_cmp_ne_u32 vcc, s47, v83
  s_cbranch_vccnz L_RR8
L_RA8:
  v_perm_b32 v83, v81, v80, s41
  v_perm_b32 v83, v82, v83, s42
  v_pk_add_f32 v[48:49], v[48:49], v[80:81]
  v_pk_add_f32 v[50:51], v[50:51], v[82:83]
  s_nop 1
  v_permlane32_swap_b32 v48, v50
  v_permlane32_swap_b32 v49, v51
  v_add_f32 v48, v48, v50
  v_add_f32 v49, v49, v51
  s_nop 1
  v_permlane16_swap_b32 v48, v49
  v_add_f32 v48, v48, v49
  s_nop 1
  v_add_f32_dpp v48, v48, v48 row_ror:4 row_mask:0xf bank_mask:0xf
  s_nop 1
  v_add_f32_dpp v48, v48, v48 row_ror:8 row_mask:0xf bank_mask:0xf
  v_cvt_pk_bf16_f32 v16, v48, v48
  v_and_b32 v16, 0xffff0000, v16
  v_mul_f32 v16, v16, v32
  v_cvt_pk_bf16_f32 v16, v16, v16
  v_and_b32 v16, 0xffff0000, v16
  s_waitcnt lgkmcnt(0)
  v_add_f32 v16, v16, v35
  v_cvt_pk_bf16_f32 v16, v16, v16
  s_mov_b32 exec_lo, 0x000f000f
  s_mov_b32 exec_hi, 0x000f000f
  buffer_store_short v16, v29, s[20:23], s50 offen
  s_cmp_lg_u32 s46, 0
  s_cbranch_scc1 L_FIN
  s_mov_b64 exec, 1
  v_mov_b32 v16, s47
  v_mov_b32 v17, 0
  buffer_store_dword v16, v17, s[16:19], 0 offen
L_FIN:
L_END:
  s_endpgm
L_RR0:
  s_sub_u32 s61, s61, 1
  s_cbranch_scc1 L_RA0
  buffer_load_dwordx4 v[48:51], v34, s[16:19], s80 offen sc1
  buffer_load_dwordx4 v[52:55], v34, s[16:19], s81 offen sc1
  buffer_load_dwordx4 v[56:59], v34, s[16:19], s82 offen sc1
  buffer_load_dwordx4 v[60:63], v34, s[16:19], s83 offen sc1
  buffer_load_dwordx4 v[64:67], v34, s[16:19], s84 offen sc1
  buffer_load_dwordx4 v[68:71], v34, s[16:19], s85 offen sc1
  buffer_load_dwordx4 v[72:75], v34, s[16:19], s86 offen sc1
  buffer_load_dwordx4 v[76:79], v34, s[16:19], s87 offen sc1
  buffer_load_dwordx4 v[80:83], v34, s[16:19], s88 offen sc1
  s_branch L_R0
L_RR1:
  s_sub_u32 s61, s61, 1
  s_cbranch_scc1 L_RA1
  buffer_load_dwordx4 v[52:55], v34, s[16:19], s81 offen sc1
  buffer_load_dwordx4 v[56:59], v34, s[16:19], s82 offen sc1
  buffer_load_dwordx4 v[60:63], v34, s[16:19], s83 offen sc1
  buffer_load_dwordx4 v[64:67], v34, s[16:19], s84 offen sc1
  buffer_load_dwordx4 v[68:71], v34, s[16:19], s85 offen sc1
  buffer_load_dwordx4 v[72:75], v34, s[16:19], s86 offen sc1
  buffer_load_dwordx4 v[76:79], v34, s[16:19], s87 offen sc1
  buffer_load_dwordx4 v[80:83], v34, s[16:19], s88 offen sc1
  s_branch L_R1
L_RR2:
  s_sub_u32 s61, s61, 1
  s_cbranch_scc1 L_RA2
  buffer_load_dwordx4 v[56:59], v34, s[16:19], s82 offen sc1
  buffer_load_dwordx4 v[60:63], v34, s[16:19], s83 offen sc1
  buffer_load_dwordx4 v[64:67], v34, s[16:19], s84 offen sc1
  buffer_load_dwordx4 v[68:71], v34, s[16:19], s85 offen sc1
  buffer_load_dwordx4 v[72:75], v34, s[16:19], s86 offen sc1
  buffer_load_dwordx4 v[76:79], v34, s[16:19], s87 offen sc1
  buffer_load_dwordx4 v[80:83], v34, s[16:19], s88 offen sc1
  s_branch L_R2
L_RR3:
  s_sub_u32 s61, s61, 1
  s_cbranch_scc1 L_RA3
  buffer_load_dwordx4 v[60:63], v34, s[16:19], s83 offen sc1
  buffer_load_dwordx4 v[64:67], v34, s[16:19], s84 offen sc1
  buffer_load_dwordx4 v[68:71], v34, s[16:19], s85 offen sc1
  buffer_load_dwordx4 v[72:75], v34, s[16:19], s86 offen sc1
  buffer_load_dwordx4 v[76:79], v34, s[16:19], s87 offen sc1
  buffer_load_dwordx4 v[80:83], v34, s[16:19], s88 offen sc1
  s_branch L_R3
L_RR4:
  s_sub_u32 s61, s61, 1
  s_cbranch_scc1 L_RA4
  buffer_load_dwordx4 v[64:67], v34, s[16:19], s84 offen sc1
  buffer_load_dwordx4 v[68:71], v34, s[16:19], s85 offen sc1
  buffer_load_dwordx4 v[72:75], v34, s[16:19], s86 offen sc1
  buffer_load_dwordx4 v[76:79], v34, s[16:19], s87 offen sc1
  buffer_load_dwordx4 v[80:83], v34, s[16:19], s88 offen sc1
  s_branch L_R4
L_RR5:
  s_sub_u32 s61, s61, 1
  s_cbranch_scc1 L_RA5
  buffer_load_dwordx4 v[68:71], v34, s[16:19], s85 offen sc1
  buffer_load_dwordx4 v[72:75], v34, s[16:19], s86 offen sc1
  buffer_load_dwordx4 v[76:79], v34, s[16:19], s87 offen sc1
  buffer_load_dwordx4 v[80:83], v34, s[16:19], s88 offen sc1
  s_branch L_R5
L_RR6:
  s_sub_u32 s61, s61, 1
  s_cbranch_scc1 L_RA6
  buffer_load_dwordx4 v[72:75], v34, s[16:19], s86 offen sc1
  buffer_load_dwordx4 v[76:79], v34, s[16:19], s87 offen sc1
  buffer_load_dwordx4 v[80:83], v34, s[16:19], s88 offen sc1
  s_branch L_R6
L_RR7:
  s_sub_u32 s61, s61, 1
  s_cbranch_scc1 L_RA7
  buffer_load_dwordx4 v[76:79], v34, s[16:19], s87 offen sc1
  buffer_load_dwordx4 v[80:83], v34, s[16:19], s88 offen sc1
  s_branch L_R7
L_RR8:
  s_sub_u32 s61, s61, 1
  s_cbranch_scc1 L_RA8
  buffer_load_dwordx4 v[80:83], v34, s[16:19], s88 offen sc1
  s_branch L_R8
L_CODE_END:
L_FIX1:
  s_mov_b32 s98, 1
  s_branch L_FIX
L_FIX2:
  s_mov_b32 s98, 2
  s_branch L_FIX
L_FIX:
  s_mov_b32 s29, 0x07060302
  v_lshlrev_b32 v12, 16, v84
  v_and_b32 v13, 0xffff0000, v84
  v_fma_f32 v12, v12, 0, v12
  v_fma_f32 v13, v13, 0, v13
  v_perm_b32 v84, v13, v12, s29
  v_lshlrev_b32 v12, 16, v85
  v_and_b32 v13, 0xffff0000, v85
  v_fma_f32 v12, v12, 0, v12
  v_fma_f32 v13, v13, 0, v13
  v_perm_b32 v85, v13, v12, s29
  v_lshlrev_b32 v12, 16, v86
  v_and_b32 v13, 0xffff0000, v86
  v_fma_f32 v12, v12, 0, v12
  v_fma_f32 v13, v13, 0, v13
  v_perm_b32 v86, v13, v12, s29
  v_lshlrev_b32 v12, 16, v87
  v_and_b32 v13, 0xffff0000, v87
  v_fma_f32 v12, v12, 0, v12
  v_fma_f32 v13, v13, 0, v13
  v_perm_b32 v87, v13, v12, s29
  v_lshlrev_b32 v12, 16, v88
  v_and_b32 v13, 0xffff0000, v88
  v_fma_f32 v12, v12, 0, v12
  v_fma_f32 v13, v13, 0, v13
  v_perm_b32 v88, v13, v12, s29
  v_lshlrev_b32 v12, 16, v89
  v_and_b32 v13, 0xffff0000, v89
  v_fma_f32 v12, v12, 0, v12
  v_fma_f32 v13, v13, 0, v13
  v_perm_b32 v89, v13, v12, s29
  v_lshlrev_b32 v12, 16, v90
  v_and_b32 v13, 0xffff0000, v90
  v_fma_f32 v12, v12, 0, v12
  v_fma_f32 v13, v13, 0, v13
  v_perm_b32 v90, v13, v12, s29
  v_lshlrev_b32 v12, 16, v91
  v_and_b32 v13, 0xffff0000, v91
  v_fma_f32 v12, v12, 0, v12
  v_fma_f32 v13, v13, 0, v13
  v_perm_b32 v91, v13, v12, s29
  v_lshlrev_b32 v12, 16, v92
  v_and_b32 v13, 0xffff0000, v92
  v_fma_f32 v12, v12, 0, v12
  v_fma_f32 v13, v13, 0, v13
  v_perm_b32 v92, v13, v12, s29
  v_lshlrev_b32 v12, 16, v93
  v_and_b32 v13, 0xffff0000, v93
  v_fma_f32 v12, v12, 0, v12
  v_fma_f32 v13, v13, 0, v13
  v_perm_b32 v93, v13, v12, s29
  v_lshlrev_b32 v12, 16, v94
  v_and_b32 v13, 0xffff0000, v94
  v_fma_f32 v12, v12, 0, v12
  v_fma_f32 v13, v13, 0, v13
  v_perm_b32 v94, v13, v12, s29
  v_lshlrev_b32 v12, 16, v95
  v_and_b32 v13, 0xffff0000, v95
  v_fma_f32 v12, v12, 0, v12
  v_fma_f32 v13, v13, 0, v13
  v_perm_b32 v95, v13, v12, s29
  v_lshlrev_b32 v12, 16, v96
  v_and_b32 v13, 0xffff0000, v96
  v_fma_f32 v12, v12, 0, v12
  v_fma_f32 v13, v13, 0, v13
  v_perm_b32 v96, v13, v12, s29
  v_lshlrev_b32 v12, 16, v97
  v_and_b32 v13, 0xffff0000, v97
  v_fma_f32 v12, v12, 0, v12
  v_fma_f32 v13, v13, 0, v13
  v_perm_b32 v97, v13, v12, s29
  v_lshlrev_b32 v12, 16, v98
  v_and_b32 v13, 0xffff0000, v98
  v_fma_f32 v12, v12, 0, v12
  v_fma_f32 v13, v13, 0, v13
  v_perm_b32 v98, v13, v12, s29
  v_lshlrev_b32 v12, 16, v99
  v_and_b32 v13, 0xffff0000, v99
  v_fma_f32 v12, v12, 0, v12
  v_fma_f32 v13, v13, 0, v13
  v_perm_b32 v99, v13, v12, s29
  v_lshlrev_b32 v12, 16, v100
  v_and_b32 v13, 0xffff0000, v100
  v_fma_f32 v12, v12, 0, v12
  v_fma_f32 v13, v13, 0, v13
  v_perm_b32 v100, v13, v12, s29
  v_lshlrev_b32 v12, 16, v101
  v_and_b32 v13, 0xffff0000, v101
  v_fma_f32 v12, v12, 0, v12
  v_fma_f32 v13, v13, 0, v13
  v_perm_b32 v101, v13, v12, s29
  v_lshlrev_b32 v12, 16, v102
  v_and_b32 v13, 0xffff0000, v102
  v_fma_f32 v12, v12, 0, v12
  v_fma_f32 v13, v13, 0, v13
  v_perm_b32 v102, v13, v12, s29
  v_lshlrev_b32 v12, 16, v103
  v_and_b32 v13, 0xffff0000, v103
  v_fma_f32 v12, v12, 0, v12
  v_fma_f32 v13, v13, 0, v13
  v_perm_b32 v103, v13, v12, s29
  v_lshlrev_b32 v12, 16, v104
  v_and_b32 v13, 0xffff0000, v104
  v_fma_f32 v12, v12, 0, v12
  v_fma_f32 v13, v13, 0, v13
  v_perm_b32 v104, v13, v12, s29
  v_lshlrev_b32 v12, 16, v105
  v_and_b32 v13, 0xffff0000, v105
  v_fma_f32 v12, v12, 0, v12
  v_fma_f32 v13, v13, 0, v13
  v_perm_b32 v105, v13, v12, s29
  v_lshlrev_b32 v12, 16, v106
  v_and_b32 v13, 0xffff0000, v106
  v_fma_f32 v12, v12, 0, v12
  v_fma_f32 v13, v13, 0, v13
  v_perm_b32 v106, v13, v12, s29
  v_lshlrev_b32 v12, 16, v107
  v_and_b32 v13, 0xffff0000, v107
  v_fma_f32 v12, v12, 0, v12
  v_fma_f32 v13, v13, 0, v13
  v_perm_b32 v107, v13, v12, s29
  v_lshlrev_b32 v12, 16, v108
  v_and_b32 v13, 0xffff0000, v108
  v_fma_f32 v12, v12, 0, v12
  v_fma_f32 v13, v13, 0, v13
  v_perm_b32 v108, v13, v12, s29
  v_lshlrev_b32 v12, 16, v109
  v_and_b32 v13, 0xffff0000, v109
  v_fma_f32 v12, v12, 0, v12
  v_fma_f32 v13, v13, 0, v13
  v_perm_b32 v109, v13, v12, s29
  v_lshlrev_b32 v12, 16, v110
  v_and_b32 v13, 0xffff0000, v110
  v_fma_f32 v12, v12, 0, v12
  v_fma_f32 v13, v13, 0, v13
  v_perm_b32 v110, v13, v12, s29
  v_lshlrev_b32 v12, 16, v111
  v_and_b32 v13, 0xffff0000, v111
  v_fma_f32 v12, v12, 0, v12
  v_fma_f32 v13, v13, 0, v13
  v_perm_b32 v111, v13, v12, s29
  v_lshlrev_b32 v12, 16, v112
  v_and_b32 v13, 0xffff0000, v112
  v_fma_f32 v12, v12, 0, v12
  v_fma_f32 v13, v13, 0, v13
  v_perm_b32 v112, v13, v12, s29
  v_lshlrev_b32 v12, 16, v113
  v_and_b32 v13, 0xffff0000, v113
  v_fma_f32 v12, v12, 0, v12
  v_fma_f32 v13, v13, 0, v13
  v_perm_b32 v113, v13, v12, s29
  v_lshlrev_b32 v12, 16, v114
  v_and_b32 v13, 0xffff0000, v114
  v_fma_f32 v12, v12, 0, v12
  v_fma_f32 v13, v13, 0, v13
  v_perm_b32 v114, v13, v12, s29
  v_lshlrev_b32 v12, 16, v115
  v_and_b32 v13, 0xffff0000, v115
  v_fma_f32 v12, v12, 0, v12
  v_fma_f32 v13, v13, 0, v13
  v_perm_b32 v115, v13, v12, s29
  v_lshlrev_b32 v12, 16, v116
  v_and_b32 v13, 0xffff0000, v116
  v_fma_f32 v12, v12, 0, v12
  v_fma_f32 v13, v13, 0, v13
  v_perm_b32 v116, v13, v12, s29
  v_lshlrev_b32 v12, 16, v117
  v_and_b32 v13, 0xffff0000, v117
  v_fma_f32 v12, v12, 0, v12
  v_fma_f32 v13, v13, 0, v13
  v_perm_b32 v117, v13, v12, s29
  v_lshlrev_b32 v12, 16, v118
  v_and_b32 v13, 0xffff0000, v118
  v_fma_f32 v12, v12, 0, v12
  v_fma_f32 v13, v13, 0, v13
  v_perm_b32 v118, v13, v12, s29
  v_lshlrev_b32 v12, 16, v119
  v_and_b32 v13, 0xffff0000, v119
  v_fma_f32 v12, v12, 0, v12
  v_fma_f32 v13, v13, 0, v13
  v_perm_b32 v119, v13, v12, s29
  s_cmp_eq_u32 s98, 1
  s_cbranch_scc1 L_FIXR1
  s_branch L_FIXR2
.section .rodata,"a"
.p2align 6
.amdhsa_kernel standalone__moe_arch_mod__prompt_kernel
  .amdhsa_next_free_vgpr 200
  .amdhsa_next_free_sgpr 102
  .amdhsa_accum_offset 200
  .amdhsa_group_segment_fixed_size 0
  .amdhsa_kernarg_size 64
  .amdhsa_user_sgpr_count 2
  .amdhsa_user_sgpr_kernarg_segment_ptr 1
  .amdhsa_system_sgpr_workgroup_id_x 1
  .amdhsa_float_denorm_mode_32 3
.end_amdhsa_kernel
```
